```python
import torch

def _softmax(x, axis=-1):
    return torch.softmax(x, dim=axis)

def _gelu(x):
    return torch.nn.functional.gelu(x, approximate='tanh')

def _silu(x):
    return torch.nn.functional.silu(x)

def _sigmoid(x):
    return torch.sigmoid(x)

def _layernorm(x, axis=-1, eps=1e-05):
    m = x.mean(dim=axis, keepdim=True)
    v = x.var(dim=axis, keepdim=True, unbiased=False)
    return (x - m) / torch.sqrt(v + eps)

def _scatter_add(tgt, idx, src, axis=0):
    return tgt.clone().index_add_(axis, idx, src)

def _segment_sum(src, seg, n):
    out = torch.zeros((n,) + src.shape[1:], dtype=src.dtype)
    return out.index_add_(0, seg, src)

def _pad(x, pw):
    flat = tuple((v for pair in reversed(pw) for v in pair))
    return torch.nn.functional.pad(x, flat)
kernel_name = 'standalone__tree_speculative_verify_tree_attention_over_candidate_token_tree__sampling'

def setup_inputs():

    _w = lambda a: (lambda t: t.to(torch.bfloat16) if t.is_floating_point() else t)(torch.as_tensor(a))
    B, Hq, Hkv, T, C, D = (16, 32, 8, 1, 4096, 128)
    tree_mask = torch.zeros((B, T, T), dtype=float)
    for b in range(B):
        parent = torch.zeros(T, dtype=torch.int64)
        for i in range(1, T):
            parent[i] = int(torch.randint(0, i, (1,)).item())
        for i in range(T):
            j = i
            tree_mask[b, i, j] = 1.0
            while j > 0:
                j = parent[j]
                tree_mask[b, i, j] = 1.0
    return {'q': _w((lambda *s: torch.randn(*s, dtype=torch.bfloat16) * 0.8)(B, Hq, T, D)), 'k_cache': _w((lambda *s: torch.randn(*s, dtype=torch.bfloat16) * 0.8)(B, Hkv, C, D)), 'v_cache': _w((lambda *s: torch.randn(*s, dtype=torch.bfloat16) * 0.05)(B, Hkv, C, D)), 'k_tree': _w((lambda *s: torch.randn(*s, dtype=torch.bfloat16) * 0.8)(B, Hkv, T, D)), 'v_tree': _w((lambda *s: torch.randn(*s, dtype=torch.bfloat16) * 0.05)(B, Hkv, T, D)), 'tree_mask': _w(tree_mask)}

def reference(q, k_cache, v_cache, k_tree, v_tree, tree_mask):
    B, Hq, T, D = q.shape
    Hkv, C = (k_cache.shape[1], k_cache.shape[2])
    rep = Hq // Hkv
    kc = (lambda x, n, axis: torch.repeat_interleave(x, n, dim=axis))(k_cache, rep, axis=1)
    vc = (lambda x, n, axis: torch.repeat_interleave(x, n, dim=axis))(v_cache, rep, axis=1)
    kt = (lambda x, n, axis: torch.repeat_interleave(x, n, dim=axis))(k_tree, rep, axis=1)
    vt = (lambda x, n, axis: torch.repeat_interleave(x, n, dim=axis))(v_tree, rep, axis=1)
    k = torch.concatenate([kc, kt], axis=2)
    v = torch.concatenate([vc, vt], axis=2)
    scale = D ** (-0.5)
    scores = torch.einsum('bhqd,bhkd->bhqk', q, k) * scale
    ctx_mask = torch.ones((B, 1, T, C), dtype=scores.dtype)
    tm = tree_mask[:, None, :, :].clone()
    full_mask = torch.concatenate([ctx_mask, tm], axis=-1)
    scores = scores + (1.0 - full_mask) * -1000000000.0
    p = _softmax(scores, axis=-1)
    return torch.einsum('bhqk,bhkd->bhqd', p, v)
```

```asm
; @launch grid=(256,1,1) block=(320,1,1) lds=109568
.amdgcn_target "amdgcn-amd-amdhsa--gfx950"
.text
.globl standalone__tree_speculative_verify_tree_attention_over_candidate_token_tree__sampling_kernel
.p2align 8
.type standalone__tree_speculative_verify_tree_attention_over_candidate_token_tree__sampling_kernel,@function
standalone__tree_speculative_verify_tree_attention_over_candidate_token_tree__sampling_kernel:
    s_cmp_ge_u32 s2, 256
    s_cbranch_scc1 L_end
    s_load_dwordx16 s[4:19], s[0:1], 0
    s_load_dwordx2 s[20:21], s[0:1], 64
    s_memrealtime s[44:45]
    v_lshrrev_b32 v1, 6, v0
    v_and_b32 v0, 63, v0
    v_readfirstlane_b32 s3, v1
    s_bfe_u32 s23, s2, 0x10003
    s_lshr_b32 s22, s2, 4
    s_lshl_b32 s22, s22, 3
    s_mul_i32 s41, s23, 13
    s_xor_b32 s41, s41, s2
    s_and_b32 s41, s41, 7
    s_or_b32 s22, s22, s41
    v_lshrrev_b32 v13, 4, v0
    v_and_b32 v14, 15, v0
    v_lshlrev_b32 v10, 4, v0
    s_cmp_eq_u32 s3, 4
    s_cbranch_scc1 L_helper

    v_lshlrev_b32 v15, 6, v13
    v_xor_b32 v2, v10, v15
    v_xor_b32 v3, 16, v2
    v_xor_b32 v4, 32, v2
    v_xor_b32 v5, 48, v2
    s_lshl_b32 s40, s3, 14
    s_add_u32 s40, s40, 44032
    s_lshl_b32 s41, s22, 20
    s_lshl_b32 s32, s23, 2
    s_add_u32 s32, s32, s3
    s_lshl_b32 s32, s32, 12
    s_mov_b32 s26, 1048576
    s_mov_b32 s27, 0x20000
    s_mov_b32 m0, s40
    v_and_b32 v1, 3, v14
    v_lshlrev_b32 v92, 8, v1
    v_lshl_add_u32 v92, v13, 4, v92
    s_lshl_b32 s42, s22, 10
    v_add_u32 v92, s42, v92
    s_mov_b32 s33, s32
    s_waitcnt lgkmcnt(0)
    s_add_u32 s24, s6, s41
    s_addc_u32 s25, s7, 0
    buffer_load_dwordx4 v2, s[24:27], s32 offen offset:0 nt lds
    buffer_load_dwordx4 v3, s[24:27], s32 offen offset:1024 nt lds
    buffer_load_dwordx4 v4, s[24:27], s32 offen offset:2048 nt lds
    buffer_load_dwordx4 v5, s[24:27], s32 offen offset:3072 nt lds
    s_add_u32 m0, s40, 4096
    s_add_u32 s32, s32, 32768
    global_load_dwordx4 v[16:19], v92, s[4:5] offset:0
    global_load_dwordx4 v[20:23], v92, s[4:5] offset:64
    global_load_dwordx4 v[24:27], v92, s[4:5] offset:128
    global_load_dwordx4 v[28:31], v92, s[4:5] offset:192
    buffer_load_dwordx4 v2, s[24:27], s32 offen offset:0 nt lds
    s_add_u32 s28, s8, s41
    s_addc_u32 s29, s9, 0
    s_mov_b32 s30, 1048576
    s_mov_b32 s31, 0x20000
    v_xor_b32 v15, v13, v14
    v_lshlrev_b32 v15, 4, v15
    v_lshl_add_u32 v15, v1, 10, v15
    v_lshrrev_b32 v6, 2, v14
    v_cmp_eq_u32 vcc, 0, v6
    s_nop 1
    v_cndmask_b32 v40, 0, -1, vcc
    v_cmp_eq_u32 vcc, 1, v6
    s_nop 1
    v_cndmask_b32 v41, 0, -1, vcc
    v_cmp_eq_u32 vcc, 2, v6
    s_nop 1
    v_cndmask_b32 v42, 0, -1, vcc
    v_cmp_eq_u32 vcc, 3, v6
    s_nop 1
    v_cndmask_b32 v43, 0, -1, vcc
    v_lshl_add_u32 v6, v6, 8, v15
    v_add_u32 v6, s40, v6
    v_xor_b32 v7, 64, v6
    v_xor_b32 v8, 128, v6
    v_xor_b32 v9, 192, v6
    v_lshl_add_u32 v92, v13, 2, v1
    v_lshlrev_b32 v92, 4, v92
    s_lshl_b32 s41, s3, 13
    s_add_u32 s41, s41, 11264
    v_add_u32 v92, s41, v92
    v_lshlrev_b32 v1, 4, v1
    s_mov_b32 s37, 0x3e0293ee
    s_mov_b32 s38, 0x05040100
    s_mov_b32 s39, 0x07060302
    s_mov_b32 s36, 8
    s_cmp_eq_u32 s23, 0
    s_cselect_b32 s34, 35840, 0
    s_add_u32 s34, s34, 12560
    s_mov_b64 vcc, 0
    v_mov_b32 v11, 0xff61b1e6
    v_mov_b32 v32, 0
    v_mov_b32 v33, 0
    v_mov_b32 v34, 0
    v_mov_b32 v35, 0
    v_mov_b32 v36, 0
    v_mov_b32 v37, 0
    v_mov_b32 v38, 0
    v_mov_b32 v39, 0
    v_mov_b32 v93, 10560
    v_mov_b32 v94, 1
    s_barrier
    s_waitcnt vmcnt(8)
    buffer_load_dwordx4 v3, s[24:27], s32 offen offset:1024 nt lds
    s_waitcnt vmcnt(8)
    buffer_load_dwordx4 v4, s[24:27], s32 offen offset:2048 nt lds
    s_waitcnt vmcnt(8)
    buffer_load_dwordx4 v5, s[24:27], s32 offen offset:3072 nt lds
    s_add_u32 m0, s40, 8192
    s_add_u32 s32, s32, 32768
    s_waitcnt vmcnt(8)
    buffer_load_dwordx4 v2, s[24:27], s32 offen offset:0 nt lds
    s_branch L_k9

.p2align 6
L_kloop:
    s_waitcnt vmcnt(5)
    s_cbranch_vccnz L_w1
    s_waitcnt vmcnt(4)
L_w1:
    buffer_load_dwordx4 v2, s[24:27], s32 offen offset:0 nt lds
    s_nop 3
    ds_write_b128 v92, v[80:83]
    v_max3_f32 v11, v11, v80, v81
    v_max3_f32 v11, v11, v82, v83
    v_add_u32 v92, 256, v92
    s_waitcnt vmcnt(5)
    s_cbranch_vccnz L_w2
    s_waitcnt vmcnt(4)
L_w2:
    buffer_load_dwordx4 v3, s[24:27], s32 offen offset:1024 nt lds
    ds_read_b128 v[64:67], v6 offset:8192
    ds_read_b128 v[68:71], v7 offset:8192
    ds_read_b128 v[72:75], v8 offset:8192
    ds_read_b128 v[76:79], v9 offset:8192
    s_waitcnt vmcnt(5)
    s_cbranch_vccnz L_w3
    s_waitcnt vmcnt(4)
L_w3:
    buffer_load_dwordx4 v4, s[24:27], s32 offen offset:2048 nt lds
    s_waitcnt lgkmcnt(0)
    v_mfma_f32_16x16x32_bf16 v[80:83], v[64:67], v[16:19], 0
    v_mfma_f32_16x16x32_bf16 v[80:83], v[68:71], v[20:23], v[80:83]
    v_mfma_f32_16x16x32_bf16 v[80:83], v[72:75], v[24:27], v[80:83]
    v_mfma_f32_16x16x32_bf16 v[80:83], v[76:79], v[28:31], v[80:83]
    s_waitcnt vmcnt(5)
    s_cbranch_vccnz L_w4
    s_waitcnt vmcnt(4)
L_w4:
    buffer_load_dwordx4 v5, s[24:27], s32 offen offset:3072 nt lds
    s_add_u32 m0, s40, 4096
    s_add_u32 s32, s32, 32768
    s_waitcnt vmcnt(5)
    s_cbranch_vccnz L_w5
    s_waitcnt vmcnt(4)
L_w5:
    buffer_load_dwordx4 v2, s[24:27], s32 offen offset:0 nt lds
    s_nop 3
    ds_write_b128 v92, v[80:83]
    v_max3_f32 v11, v11, v80, v81
    v_max3_f32 v11, v11, v82, v83
    v_add_u32 v92, 256, v92
    s_waitcnt vmcnt(5)
    s_cbranch_vccnz L_w6
    s_waitcnt vmcnt(4)
L_w6:
    buffer_load_dwordx4 v3, s[24:27], s32 offen offset:1024 nt lds
    ds_read_b128 v[64:67], v6 offset:12288
    ds_read_b128 v[68:71], v7 offset:12288
    ds_read_b128 v[72:75], v8 offset:12288
    ds_read_b128 v[76:79], v9 offset:12288
    s_memrealtime s[46:47]
    s_load_dword s35, s[18:19], 0
    s_waitcnt vmcnt(5)
    s_cbranch_vccnz L_w7
    s_waitcnt vmcnt(4)
L_w7:
    buffer_load_dwordx4 v4, s[24:27], s32 offen offset:2048 nt lds
    s_waitcnt lgkmcnt(0)
    v_mfma_f32_16x16x32_bf16 v[80:83], v[64:67], v[16:19], 0
    v_mfma_f32_16x16x32_bf16 v[80:83], v[68:71], v[20:23], v[80:83]
    v_mfma_f32_16x16x32_bf16 v[80:83], v[72:75], v[24:27], v[80:83]
    v_mfma_f32_16x16x32_bf16 v[80:83], v[76:79], v[28:31], v[80:83]
    s_cmp_lg_u32 s35, 0
    s_cselect_b32 s44, s35, s44
    s_add_u32 s34, s34, 55040
    s_sub_u32 s46, s46, s44
    s_lshl_b32 s46, s46, 8
    s_cmp_gt_i32 s46, s34
    s_cselect_b64 vcc, -1, 0
    s_waitcnt vmcnt(5)
    s_cbranch_vccnz L_w8
    s_waitcnt vmcnt(4)
L_w8:
    buffer_load_dwordx4 v5, s[24:27], s32 offen offset:3072 nt lds
    s_add_u32 m0, s40, 8192
    s_add_u32 s32, s32, 32768
    s_waitcnt vmcnt(5)
    s_cbranch_vccnz L_w9
    s_waitcnt vmcnt(4)
L_w9:
    buffer_load_dwordx4 v2, s[24:27], s32 offen offset:0 nt lds
    s_nop 3
    ds_write_b128 v92, v[80:83]
    v_max3_f32 v11, v11, v80, v81
    v_max3_f32 v11, v11, v82, v83
    v_add_u32 v92, 256, v92
L_k9:
    s_waitcnt vmcnt(5)
    s_cbranch_vccnz L_w10
    s_waitcnt vmcnt(4)
L_w10:
    buffer_load_dwordx4 v3, s[24:27], s32 offen offset:1024 nt lds
    ds_read_b128 v[64:67], v6 offset:0
    ds_read_b128 v[68:71], v7 offset:0
    ds_read_b128 v[72:75], v8 offset:0
    ds_read_b128 v[76:79], v9 offset:0
    s_waitcnt vmcnt(5)
    s_cbranch_vccnz L_w11
    s_waitcnt vmcnt(4)
L_w11:
    buffer_load_dwordx4 v4, s[24:27], s32 offen offset:2048 nt lds
    s_waitcnt lgkmcnt(0)
    v_mfma_f32_16x16x32_bf16 v[80:83], v[64:67], v[16:19], 0
    v_mfma_f32_16x16x32_bf16 v[80:83], v[68:71], v[20:23], v[80:83]
    v_mfma_f32_16x16x32_bf16 v[80:83], v[72:75], v[24:27], v[80:83]
    v_mfma_f32_16x16x32_bf16 v[80:83], v[76:79], v[28:31], v[80:83]
    s_waitcnt vmcnt(5)
    s_cbranch_vccnz L_w12
    s_waitcnt vmcnt(4)
L_w12:
    buffer_load_dwordx4 v5, s[24:27], s32 offen offset:3072 nt lds
    s_add_u32 m0, s40, 12288
    s_add_u32 s32, s32, 32768
    s_waitcnt vmcnt(5)
    s_cbranch_vccnz L_w13
    s_waitcnt vmcnt(4)
L_w13:
    buffer_load_dwordx4 v2, s[24:27], s32 offen offset:0 nt lds
    s_nop 3
    ds_write_b128 v92, v[80:83]
    v_max3_f32 v11, v11, v80, v81
    v_max3_f32 v11, v11, v82, v83
    v_add_u32 v92, 256, v92
    s_waitcnt vmcnt(5)
    s_cbranch_vccnz L_w14
    s_waitcnt vmcnt(4)
L_w14:
    buffer_load_dwordx4 v3, s[24:27], s32 offen offset:1024 nt lds
    ds_read_b128 v[64:67], v6 offset:4096
    ds_read_b128 v[68:71], v7 offset:4096
    ds_read_b128 v[72:75], v8 offset:4096
    ds_read_b128 v[76:79], v9 offset:4096
    s_waitcnt vmcnt(5)
    s_cbranch_vccnz L_w15
    s_waitcnt vmcnt(4)
L_w15:
    buffer_load_dwordx4 v4, s[24:27], s32 offen offset:2048 nt lds
    s_waitcnt lgkmcnt(0)
    v_mfma_f32_16x16x32_bf16 v[80:83], v[64:67], v[16:19], 0
    v_mfma_f32_16x16x32_bf16 v[80:83], v[68:71], v[20:23], v[80:83]
    v_mfma_f32_16x16x32_bf16 v[80:83], v[72:75], v[24:27], v[80:83]
    v_mfma_f32_16x16x32_bf16 v[80:83], v[76:79], v[28:31], v[80:83]
    s_waitcnt vmcnt(5)
    s_cbranch_vccnz L_w16
    s_waitcnt vmcnt(4)
L_w16:
    buffer_load_dwordx4 v5, s[24:27], s32 offen offset:3072 nt lds
    s_add_u32 m0, s40, 0
    s_add_u32 s32, s32, 32768
    s_sub_u32 s36, s36, 1
    s_cmp_lg_u32 s36, 0
    s_cbranch_scc1 L_kloop

    s_waitcnt vmcnt(5)
    s_cbranch_vccnz L_w17
    s_waitcnt vmcnt(4)
L_w17:
    buffer_load_dwordx4 v[128:131], v10, s[28:31], s33 offen offset:0 nt
    s_nop 3
    ds_write_b128 v92, v[80:83]
    v_max3_f32 v11, v11, v80, v81
    v_max3_f32 v11, v11, v82, v83
    v_add_u32 v92, 256, v92
    s_waitcnt vmcnt(5)
    s_cbranch_vccnz L_w18
    s_waitcnt vmcnt(4)
L_w18:
    buffer_load_dwordx4 v[132:135], v10, s[28:31], s33 offen offset:1024 nt
    ds_read_b128 v[64:67], v6 offset:8192
    ds_read_b128 v[68:71], v7 offset:8192
    ds_read_b128 v[72:75], v8 offset:8192
    ds_read_b128 v[76:79], v9 offset:8192
    s_waitcnt vmcnt(5)
    s_cbranch_vccnz L_w19
    s_waitcnt vmcnt(4)
L_w19:
    buffer_load_dwordx4 v[136:139], v10, s[28:31], s33 offen offset:2048 nt
    s_waitcnt lgkmcnt(0)
    v_mfma_f32_16x16x32_bf16 v[80:83], v[64:67], v[16:19], 0
    v_mfma_f32_16x16x32_bf16 v[80:83], v[68:71], v[20:23], v[80:83]
    v_mfma_f32_16x16x32_bf16 v[80:83], v[72:75], v[24:27], v[80:83]
    v_mfma_f32_16x16x32_bf16 v[80:83], v[76:79], v[28:31], v[80:83]
    s_waitcnt vmcnt(5)
    s_cbranch_vccnz L_w20
    s_waitcnt vmcnt(4)
L_w20:
    buffer_load_dwordx4 v[140:143], v10, s[28:31], s33 offen offset:3072 nt
    s_add_u32 s33, s33, 32768
    s_waitcnt vmcnt(5)
    s_cbranch_vccnz L_w21
    s_waitcnt vmcnt(4)
L_w21:
    buffer_load_dwordx4 v[144:147], v10, s[28:31], s33 offen offset:0 nt
    s_nop 3
    ds_write_b128 v92, v[80:83]
    v_max3_f32 v11, v11, v80, v81
    v_max3_f32 v11, v11, v82, v83
    v_add_u32 v92, 256, v92
    s_waitcnt vmcnt(5)
    s_cbranch_vccnz L_w22
    s_waitcnt vmcnt(4)
L_w22:
    buffer_load_dwordx4 v[148:151], v10, s[28:31], s33 offen offset:1024 nt
    ds_read_b128 v[64:67], v6 offset:12288
    ds_read_b128 v[68:71], v7 offset:12288
    ds_read_b128 v[72:75], v8 offset:12288
    ds_read_b128 v[76:79], v9 offset:12288
    s_waitcnt vmcnt(5)
    s_cbranch_vccnz L_w23
    s_waitcnt vmcnt(4)
L_w23:
    buffer_load_dwordx4 v[152:155], v10, s[28:31], s33 offen offset:2048 nt
    s_waitcnt lgkmcnt(0)
    v_mfma_f32_16x16x32_bf16 v[80:83], v[64:67], v[16:19], 0
    v_mfma_f32_16x16x32_bf16 v[80:83], v[68:71], v[20:23], v[80:83]
    v_mfma_f32_16x16x32_bf16 v[80:83], v[72:75], v[24:27], v[80:83]
    v_mfma_f32_16x16x32_bf16 v[80:83], v[76:79], v[28:31], v[80:83]
    s_waitcnt vmcnt(5)
    s_cbranch_vccnz L_w24
    s_waitcnt vmcnt(4)
L_w24:
    buffer_load_dwordx4 v[156:159], v10, s[28:31], s33 offen offset:3072 nt
    s_add_u32 s33, s33, 32768
    s_nop 3
    s_nop 3
    ds_write_b128 v92, v[80:83]
    v_max3_f32 v11, v11, v80, v81
    v_max3_f32 v11, v11, v82, v83
    v_add_u32 v92, 256, v92
    v_mov_b32 v14, v11
    v_subrev_u32 v92, 8192, v92
    s_lshl_b32 s41, s3, 2
    v_permlane16_swap_b32 v11, v14
    v_max_f32 v11, v11, v14
    v_mov_b32 v14, v11
    v_add_u32 v15, s41, v1
    s_mov_b32 s36, 7
    v_permlane32_swap_b32 v11, v14
    v_max_f32 v11, v11, v14
    ds_write_b32 v15, v11 offset:10496
    s_mov_b64 exec, 1
    s_waitcnt lgkmcnt(0)
    ds_add_u32 v93, v94 offset:8
    s_mov_b64 exec, -1
    s_waitcnt vmcnt(5)
    s_cbranch_vccnz L_w25
    s_waitcnt vmcnt(4)
L_w25:
    buffer_load_dwordx4 v[160:163], v10, s[28:31], s33 offen offset:0 nt
    s_waitcnt vmcnt(5)
    s_cbranch_vccnz L_w26
    s_waitcnt vmcnt(4)
L_w26:
    buffer_load_dwordx4 v[164:167], v10, s[28:31], s33 offen offset:1024 nt
    s_add_u32 s34, s34, 13760
L_msync:
    ds_read_b32 v14, v93 offset:8
    ds_read_b128 v[44:47], v1 offset:10496
    s_waitcnt lgkmcnt(0)
    v_readfirstlane_b32 s41, v14
    s_cmp_lg_u32 s41, 4
    s_cbranch_scc1 L_msync
    v_max3_f32 v11, v44, v45, v46
    v_max_f32 v11, v11, v47
    v_mul_f32 v11, s37, v11

.p2align 6
L_vloop:
    s_waitcnt vmcnt(5)
    s_cbranch_vccnz L_w27
    s_waitcnt vmcnt(4)
L_w27:
    buffer_load_dwordx4 v[168:171], v10, s[28:31], s33 offen offset:2048 nt
    ds_read_b128 v[80:83], v92
    ds_read_b128 v[84:87], v92 offset:256
    s_memrealtime s[46:47]
    v_add_u32 v92, 512, v92
    s_waitcnt vmcnt(5)
    s_cbranch_vccnz L_w28
    s_waitcnt vmcnt(4)
L_w28:
    buffer_load_dwordx4 v[172:175], v10, s[28:31], s33 offen offset:3072 nt
    s_add_u32 s33, s33, 32768
    v_perm_b32 v96, v132, v128, s38
    v_perm_b32 v100, v132, v128, s39
    v_perm_b32 v104, v133, v129, s38
    v_perm_b32 v108, v133, v129, s39
    v_perm_b32 v112, v134, v130, s38
    v_perm_b32 v116, v134, v130, s39
    v_perm_b32 v120, v135, v131, s38
    v_perm_b32 v124, v135, v131, s39
    s_waitcnt vmcnt(5)
    s_cbranch_vccnz L_w29
    s_waitcnt vmcnt(4)
L_w29:
    buffer_load_dwordx4 v[176:179], v10, s[28:31], s33 offen offset:0 nt
    s_waitcnt lgkmcnt(0)
    s_add_u32 s34, s34, 55040
    s_sub_u32 s46, s46, s44
    s_lshl_b32 s46, s46, 8
    s_cmp_gt_i32 s46, s34
    s_cselect_b64 vcc, -1, 0
    v_fma_f32 v80, v80, s37, -v11
    v_fma_f32 v81, v81, s37, -v11
    v_fma_f32 v82, v82, s37, -v11
    v_fma_f32 v83, v83, s37, -v11
    v_fma_f32 v84, v84, s37, -v11
    v_fma_f32 v85, v85, s37, -v11
    v_fma_f32 v86, v86, s37, -v11
    v_fma_f32 v87, v87, s37, -v11
    v_exp_f32 v80, v80
    v_exp_f32 v81, v81
    v_exp_f32 v82, v82
    v_exp_f32 v83, v83
    v_exp_f32 v84, v84
    v_exp_f32 v85, v85
    v_exp_f32 v86, v86
    v_exp_f32 v87, v87
    s_waitcnt vmcnt(5)
    s_cbranch_vccnz L_w30
    s_waitcnt vmcnt(4)
L_w30:
    buffer_load_dwordx4 v[180:183], v10, s[28:31], s33 offen offset:1024 nt
    v_perm_b32 v97, v140, v136, s38
    v_perm_b32 v101, v140, v136, s39
    v_perm_b32 v105, v141, v137, s38
    v_perm_b32 v109, v141, v137, s39
    v_perm_b32 v113, v142, v138, s38
    v_perm_b32 v117, v142, v138, s39
    v_perm_b32 v121, v143, v139, s38
    v_perm_b32 v125, v143, v139, s39
    s_waitcnt vmcnt(5)
    s_cbranch_vccnz L_w31
    s_waitcnt vmcnt(4)
L_w31:
    buffer_load_dwordx4 v[184:187], v10, s[28:31], s33 offen offset:2048 nt
    v_cvt_pk_bf16_f32 v44, v80, v81
    v_cvt_pk_bf16_f32 v45, v82, v83
    v_cvt_pk_bf16_f32 v46, v84, v85
    v_cvt_pk_bf16_f32 v47, v86, v87
    v_and_b32 v48, v40, v44
    v_and_b32 v49, v40, v45
    v_and_b32 v50, v40, v46
    v_and_b32 v51, v40, v47
    v_and_b32 v52, v41, v44
    v_and_b32 v53, v41, v45
    v_and_b32 v54, v41, v46
    v_and_b32 v55, v41, v47
    s_waitcnt vmcnt(5)
    s_cbranch_vccnz L_w32
    s_waitcnt vmcnt(4)
L_w32:
    buffer_load_dwordx4 v[188:191], v10, s[28:31], s33 offen offset:3072 nt
    s_add_u32 s33, s33, 32768
    v_perm_b32 v98, v148, v144, s38
    v_perm_b32 v102, v148, v144, s39
    v_perm_b32 v106, v149, v145, s38
    v_perm_b32 v110, v149, v145, s39
    v_perm_b32 v114, v150, v146, s38
    v_perm_b32 v118, v150, v146, s39
    v_perm_b32 v122, v151, v147, s38
    v_perm_b32 v126, v151, v147, s39
    s_waitcnt vmcnt(5)
    s_cbranch_vccnz L_w33
    s_waitcnt vmcnt(4)
L_w33:
    buffer_load_dwordx4 v[128:131], v10, s[28:31], s33 offen offset:0 nt
    v_and_b32 v56, v42, v44
    v_and_b32 v57, v42, v45
    v_and_b32 v58, v42, v46
    v_and_b32 v59, v42, v47
    v_and_b32 v60, v43, v44
    v_and_b32 v61, v43, v45
    v_and_b32 v62, v43, v46
    v_and_b32 v63, v43, v47
    s_waitcnt vmcnt(5)
    s_cbranch_vccnz L_w34
    s_waitcnt vmcnt(4)
L_w34:
    buffer_load_dwordx4 v[132:135], v10, s[28:31], s33 offen offset:1024 nt
    v_perm_b32 v99, v156, v152, s38
    v_perm_b32 v103, v156, v152, s39
    v_perm_b32 v107, v157, v153, s38
    v_perm_b32 v111, v157, v153, s39
    v_perm_b32 v115, v158, v154, s38
    v_perm_b32 v119, v158, v154, s39
    v_perm_b32 v123, v159, v155, s38
    v_perm_b32 v127, v159, v155, s39
    v_mfma_f32_16x16x32_bf16 v[32:35], v[96:99], v[48:51], v[32:35]
    v_mfma_f32_16x16x32_bf16 v[36:39], v[100:103], v[48:51], v[36:39]
    v_mfma_f32_16x16x32_bf16 v[32:35], v[104:107], v[52:55], v[32:35]
    v_mfma_f32_16x16x32_bf16 v[36:39], v[108:111], v[52:55], v[36:39]
    v_mfma_f32_16x16x32_bf16 v[32:35], v[112:115], v[56:59], v[32:35]
    v_mfma_f32_16x16x32_bf16 v[36:39], v[116:119], v[56:59], v[36:39]
    v_mfma_f32_16x16x32_bf16 v[32:35], v[120:123], v[60:63], v[32:35]
    v_mfma_f32_16x16x32_bf16 v[36:39], v[124:127], v[60:63], v[36:39]
    s_waitcnt vmcnt(5)
    s_cbranch_vccnz L_w35
    s_waitcnt vmcnt(4)
L_w35:
    buffer_load_dwordx4 v[136:139], v10, s[28:31], s33 offen offset:2048 nt
    ds_read_b128 v[80:83], v92
    ds_read_b128 v[84:87], v92 offset:256
    v_add_u32 v92, 512, v92
    s_waitcnt vmcnt(5)
    s_cbranch_vccnz L_w36
    s_waitcnt vmcnt(4)
L_w36:
    buffer_load_dwordx4 v[140:143], v10, s[28:31], s33 offen offset:3072 nt
    s_add_u32 s33, s33, 32768
    v_perm_b32 v96, v164, v160, s38
    v_perm_b32 v100, v164, v160, s39
    v_perm_b32 v104, v165, v161, s38
    v_perm_b32 v108, v165, v161, s39
    v_perm_b32 v112, v166, v162, s38
    v_perm_b32 v116, v166, v162, s39
    v_perm_b32 v120, v167, v163, s38
    v_perm_b32 v124, v167, v163, s39
    s_waitcnt vmcnt(5)
    s_cbranch_vccnz L_w37
    s_waitcnt vmcnt(4)
L_w37:
    buffer_load_dwordx4 v[144:147], v10, s[28:31], s33 offen offset:0 nt
    s_waitcnt lgkmcnt(0)
    v_fma_f32 v80, v80, s37, -v11
    v_fma_f32 v81, v81, s37, -v11
    v_fma_f32 v82, v82, s37, -v11
    v_fma_f32 v83, v83, s37, -v11
    v_fma_f32 v84, v84, s37, -v11
    v_fma_f32 v85, v85, s37, -v11
    v_fma_f32 v86, v86, s37, -v11
    v_fma_f32 v87, v87, s37, -v11
    v_exp_f32 v80, v80
    v_exp_f32 v81, v81
    v_exp_f32 v82, v82
    v_exp_f32 v83, v83
    v_exp_f32 v84, v84
    v_exp_f32 v85, v85
    v_exp_f32 v86, v86
    v_exp_f32 v87, v87
    s_waitcnt vmcnt(5)
    s_cbranch_vccnz L_w38
    s_waitcnt vmcnt(4)
L_w38:
    buffer_load_dwordx4 v[148:151], v10, s[28:31], s33 offen offset:1024 nt
    v_perm_b32 v97, v172, v168, s38
    v_perm_b32 v101, v172, v168, s39
    v_perm_b32 v105, v173, v169, s38
    v_perm_b32 v109, v173, v169, s39
    v_perm_b32 v113, v174, v170, s38
    v_perm_b32 v117, v174, v170, s39
    v_perm_b32 v121, v175, v171, s38
    v_perm_b32 v125, v175, v171, s39
    s_waitcnt vmcnt(5)
    s_cbranch_vccnz L_w39
    s_waitcnt vmcnt(4)
L_w39:
    buffer_load_dwordx4 v[152:155], v10, s[28:31], s33 offen offset:2048 nt
    v_cvt_pk_bf16_f32 v44, v80, v81
    v_cvt_pk_bf16_f32 v45, v82, v83
    v_cvt_pk_bf16_f32 v46, v84, v85
    v_cvt_pk_bf16_f32 v47, v86, v87
    v_and_b32 v48, v40, v44
    v_and_b32 v49, v40, v45
    v_and_b32 v50, v40, v46
    v_and_b32 v51, v40, v47
    v_and_b32 v52, v41, v44
    v_and_b32 v53, v41, v45
    v_and_b32 v54, v41, v46
    v_and_b32 v55, v41, v47
    s_waitcnt vmcnt(5)
    s_cbranch_vccnz L_w40
    s_waitcnt vmcnt(4)
L_w40:
    buffer_load_dwordx4 v[156:159], v10, s[28:31], s33 offen offset:3072 nt
    s_add_u32 s33, s33, 32768
    v_perm_b32 v98, v180, v176, s38
    v_perm_b32 v102, v180, v176, s39
    v_perm_b32 v106, v181, v177, s38
    v_perm_b32 v110, v181, v177, s39
    v_perm_b32 v114, v182, v178, s38
    v_perm_b32 v118, v182, v178, s39
    v_perm_b32 v122, v183, v179, s38
    v_perm_b32 v126, v183, v179, s39
    s_waitcnt vmcnt(5)
    s_cbranch_vccnz L_w41
    s_waitcnt vmcnt(4)
L_w41:
    buffer_load_dwordx4 v[160:163], v10, s[28:31], s33 offen offset:0 nt
    v_and_b32 v56, v42, v44
    v_and_b32 v57, v42, v45
    v_and_b32 v58, v42, v46
    v_and_b32 v59, v42, v47
    v_and_b32 v60, v43, v44
    v_and_b32 v61, v43, v45
    v_and_b32 v62, v43, v46
    v_and_b32 v63, v43, v47
    s_waitcnt vmcnt(5)
    s_cbranch_vccnz L_w42
    s_waitcnt vmcnt(4)
L_w42:
    buffer_load_dwordx4 v[164:167], v10, s[28:31], s33 offen offset:1024 nt
    v_perm_b32 v99, v188, v184, s38
    v_perm_b32 v103, v188, v184, s39
    v_perm_b32 v107, v189, v185, s38
    v_perm_b32 v111, v189, v185, s39
    v_perm_b32 v115, v190, v186, s38
    v_perm_b32 v119, v190, v186, s39
    v_perm_b32 v123, v191, v187, s38
    v_perm_b32 v127, v191, v187, s39
    v_mfma_f32_16x16x32_bf16 v[32:35], v[96:99], v[48:51], v[32:35]
    v_mfma_f32_16x16x32_bf16 v[36:39], v[100:103], v[48:51], v[36:39]
    v_mfma_f32_16x16x32_bf16 v[32:35], v[104:107], v[52:55], v[32:35]
    v_mfma_f32_16x16x32_bf16 v[36:39], v[108:111], v[52:55], v[36:39]
    v_mfma_f32_16x16x32_bf16 v[32:35], v[112:115], v[56:59], v[32:35]
    v_mfma_f32_16x16x32_bf16 v[36:39], v[116:119], v[56:59], v[36:39]
    v_mfma_f32_16x16x32_bf16 v[32:35], v[120:123], v[60:63], v[32:35]
    v_mfma_f32_16x16x32_bf16 v[36:39], v[124:127], v[60:63], v[36:39]
    s_sub_u32 s36, s36, 1
    s_cmp_lg_u32 s36, 0
    s_cbranch_scc1 L_vloop

    s_lshl_b32 s41, s3, 11
    v_add_u32 v95, s41, v10
    v_and_b32 v13, 3, v0
    v_lshlrev_b32 v13, 8, v13
    v_and_b32 v14, 0x30, v0
    v_lshl_add_u32 v13, v14, 2, v13
    v_and_b32 v14, 12, v0
    v_add_u32 v13, v13, v14
    s_lshl_b32 s41, s22, 10
    v_add_u32 v13, s41, v13
    s_lshl_b32 s41, s22, 13
    s_add_u32 s41, s41, 2048
    v_add_u32 v12, s41, v10
    v_lshlrev_b32 v15, 2, v0
    s_waitcnt vmcnt(5)
    s_cbranch_vccnz L_w43
    s_waitcnt vmcnt(4)
L_w43:
    buffer_load_dwordx4 v[168:171], v10, s[28:31], s33 offen offset:2048 nt
    ds_read_b128 v[80:83], v92
    ds_read_b128 v[84:87], v92 offset:256
    s_memrealtime s[46:47]
    v_add_u32 v92, 512, v92
    s_cmp_eq_u32 s23, 0
    s_cbranch_scc0 L_noflush
    buffer_load_dwordx4 v[172:175], v10, s[28:31], s33 offen offset:3072 nt
    s_add_u32 s33, s33, 32768
    buffer_load_dwordx4 v[176:179], v10, s[28:31], s33 offen offset:0 nt
    buffer_load_dwordx4 v[180:183], v10, s[28:31], s33 offen offset:1024 nt
    buffer_load_dwordx4 v[184:187], v10, s[28:31], s33 offen offset:2048 nt
    buffer_load_dwordx4 v[188:191], v10, s[28:31], s33 offen offset:3072 nt
    s_add_u32 s33, s33, 32768
    s_waitcnt vmcnt(14)
    v_perm_b32 v96, v132, v128, s38
    v_perm_b32 v100, v132, v128, s39
    v_perm_b32 v104, v133, v129, s38
    v_perm_b32 v108, v133, v129, s39
    v_perm_b32 v112, v134, v130, s38
    v_perm_b32 v116, v134, v130, s39
    v_perm_b32 v120, v135, v131, s38
    v_perm_b32 v124, v135, v131, s39
    s_waitcnt lgkmcnt(0)
    v_fma_f32 v80, v80, s37, -v11
    v_fma_f32 v81, v81, s37, -v11
    v_fma_f32 v82, v82, s37, -v11
    v_fma_f32 v83, v83, s37, -v11
    v_fma_f32 v84, v84, s37, -v11
    v_fma_f32 v85, v85, s37, -v11
    v_fma_f32 v86, v86, s37, -v11
    v_fma_f32 v87, v87, s37, -v11
    v_exp_f32 v80, v80
    v_exp_f32 v81, v81
    v_exp_f32 v82, v82
    v_exp_f32 v83, v83
    v_exp_f32 v84, v84
    v_exp_f32 v85, v85
    v_exp_f32 v86, v86
    v_exp_f32 v87, v87
    s_waitcnt vmcnt(12)
    v_perm_b32 v97, v140, v136, s38
    v_perm_b32 v101, v140, v136, s39
    v_perm_b32 v105, v141, v137, s38
    v_perm_b32 v109, v141, v137, s39
    v_perm_b32 v113, v142, v138, s38
    v_perm_b32 v117, v142, v138, s39
    v_perm_b32 v121, v143, v139, s38
    v_perm_b32 v125, v143, v139, s39
    v_cvt_pk_bf16_f32 v44, v80, v81
    v_cvt_pk_bf16_f32 v45, v82, v83
    v_cvt_pk_bf16_f32 v46, v84, v85
    v_cvt_pk_bf16_f32 v47, v86, v87
    v_and_b32 v48, v40, v44
    v_and_b32 v49, v40, v45
    v_and_b32 v50, v40, v46
    v_and_b32 v51, v40, v47
    v_and_b32 v52, v41, v44
    v_and_b32 v53, v41, v45
    v_and_b32 v54, v41, v46
    v_and_b32 v55, v41, v47
    s_waitcnt vmcnt(10)
    v_perm_b32 v98, v148, v144, s38
    v_perm_b32 v102, v148, v144, s39
    v_perm_b32 v106, v149, v145, s38
    v_perm_b32 v110, v149, v145, s39
    v_perm_b32 v114, v150, v146, s38
    v_perm_b32 v118, v150, v146, s39
    v_perm_b32 v122, v151, v147, s38
    v_perm_b32 v126, v151, v147, s39
    s_branch L_flushed
L_noflush:
    s_waitcnt vmcnt(5)
    s_cbranch_vccnz L_w44
    s_waitcnt vmcnt(4)
L_w44:
    buffer_load_dwordx4 v[172:175], v10, s[28:31], s33 offen offset:3072 nt
    s_add_u32 s33, s33, 32768
    v_perm_b32 v96, v132, v128, s38
    v_perm_b32 v100, v132, v128, s39
    v_perm_b32 v104, v133, v129, s38
    v_perm_b32 v108, v133, v129, s39
    v_perm_b32 v112, v134, v130, s38
    v_perm_b32 v116, v134, v130, s39
    v_perm_b32 v120, v135, v131, s38
    v_perm_b32 v124, v135, v131, s39
    s_waitcnt vmcnt(5)
    s_cbranch_vccnz L_w45
    s_waitcnt vmcnt(4)
L_w45:
    buffer_load_dwordx4 v[176:179], v10, s[28:31], s33 offen offset:0 nt
    s_waitcnt lgkmcnt(0)
    s_add_u32 s34, s34, 55040
    s_sub_u32 s46, s46, s44
    s_lshl_b32 s46, s46, 8
    s_cmp_gt_i32 s46, s34
    s_cselect_b64 vcc, -1, 0
    v_fma_f32 v80, v80, s37, -v11
    v_fma_f32 v81, v81, s37, -v11
    v_fma_f32 v82, v82, s37, -v11
    v_fma_f32 v83, v83, s37, -v11
    v_fma_f32 v84, v84, s37, -v11
    v_fma_f32 v85, v85, s37, -v11
    v_fma_f32 v86, v86, s37, -v11
    v_fma_f32 v87, v87, s37, -v11
    v_exp_f32 v80, v80
    v_exp_f32 v81, v81
    v_exp_f32 v82, v82
    v_exp_f32 v83, v83
    v_exp_f32 v84, v84
    v_exp_f32 v85, v85
    v_exp_f32 v86, v86
    v_exp_f32 v87, v87
    s_waitcnt vmcnt(5)
    s_cbranch_vccnz L_w46
    s_waitcnt vmcnt(4)
L_w46:
    buffer_load_dwordx4 v[180:183], v10, s[28:31], s33 offen offset:1024 nt
    v_perm_b32 v97, v140, v136, s38
    v_perm_b32 v101, v140, v136, s39
    v_perm_b32 v105, v141, v137, s38
    v_perm_b32 v109, v141, v137, s39
    v_perm_b32 v113, v142, v138, s38
    v_perm_b32 v117, v142, v138, s39
    v_perm_b32 v121, v143, v139, s38
    v_perm_b32 v125, v143, v139, s39
    s_waitcnt vmcnt(5)
    s_cbranch_vccnz L_w47
    s_waitcnt vmcnt(4)
L_w47:
    buffer_load_dwordx4 v[184:187], v10, s[28:31], s33 offen offset:2048 nt
    v_cvt_pk_bf16_f32 v44, v80, v81
    v_cvt_pk_bf16_f32 v45, v82, v83
    v_cvt_pk_bf16_f32 v46, v84, v85
    v_cvt_pk_bf16_f32 v47, v86, v87
    v_and_b32 v48, v40, v44
    v_and_b32 v49, v40, v45
    v_and_b32 v50, v40, v46
    v_and_b32 v51, v40, v47
    v_and_b32 v52, v41, v44
    v_and_b32 v53, v41, v45
    v_and_b32 v54, v41, v46
    v_and_b32 v55, v41, v47
    s_waitcnt vmcnt(5)
    s_cbranch_vccnz L_w48
    s_waitcnt vmcnt(4)
L_w48:
    buffer_load_dwordx4 v[188:191], v10, s[28:31], s33 offen offset:3072 nt
    s_add_u32 s33, s33, 32768
    v_perm_b32 v98, v148, v144, s38
    v_perm_b32 v102, v148, v144, s39
    v_perm_b32 v106, v149, v145, s38
    v_perm_b32 v110, v149, v145, s39
    v_perm_b32 v114, v150, v146, s38
    v_perm_b32 v118, v150, v146, s39
    v_perm_b32 v122, v151, v147, s38
    v_perm_b32 v126, v151, v147, s39
L_flushed:
    v_and_b32 v56, v42, v44
    v_and_b32 v57, v42, v45
    v_and_b32 v58, v42, v46
    v_and_b32 v59, v42, v47
    v_and_b32 v60, v43, v44
    v_and_b32 v61, v43, v45
    v_and_b32 v62, v43, v46
    v_and_b32 v63, v43, v47
    s_waitcnt vmcnt(8)
    v_perm_b32 v99, v156, v152, s38
    v_perm_b32 v103, v156, v152, s39
    v_perm_b32 v107, v157, v153, s38
    v_perm_b32 v111, v157, v153, s39
    v_perm_b32 v115, v158, v154, s38
    v_perm_b32 v119, v158, v154, s39
    v_perm_b32 v123, v159, v155, s38
    v_perm_b32 v127, v159, v155, s39
    v_mfma_f32_16x16x32_bf16 v[32:35], v[96:99], v[48:51], v[32:35]
    v_mfma_f32_16x16x32_bf16 v[36:39], v[100:103], v[48:51], v[36:39]
    v_mfma_f32_16x16x32_bf16 v[32:35], v[104:107], v[52:55], v[32:35]
    v_mfma_f32_16x16x32_bf16 v[36:39], v[108:111], v[52:55], v[36:39]
    v_mfma_f32_16x16x32_bf16 v[32:35], v[112:115], v[56:59], v[32:35]
    v_mfma_f32_16x16x32_bf16 v[36:39], v[116:119], v[56:59], v[36:39]
    v_mfma_f32_16x16x32_bf16 v[32:35], v[120:123], v[60:63], v[32:35]
    v_mfma_f32_16x16x32_bf16 v[36:39], v[124:127], v[60:63], v[36:39]
    ds_read_b128 v[80:83], v92
    ds_read_b128 v[84:87], v92 offset:256
    v_add_u32 v92, 512, v92
    s_waitcnt vmcnt(6)
    v_perm_b32 v96, v164, v160, s38
    v_perm_b32 v100, v164, v160, s39
    v_perm_b32 v104, v165, v161, s38
    v_perm_b32 v108, v165, v161, s39
    v_perm_b32 v112, v166, v162, s38
    v_perm_b32 v116, v166, v162, s39
    v_perm_b32 v120, v167, v163, s38
    v_perm_b32 v124, v167, v163, s39
    s_waitcnt lgkmcnt(0)
    v_fma_f32 v80, v80, s37, -v11
    v_fma_f32 v81, v81, s37, -v11
    v_fma_f32 v82, v82, s37, -v11
    v_fma_f32 v83, v83, s37, -v11
    v_fma_f32 v84, v84, s37, -v11
    v_fma_f32 v85, v85, s37, -v11
    v_fma_f32 v86, v86, s37, -v11
    v_fma_f32 v87, v87, s37, -v11
    v_exp_f32 v80, v80
    v_exp_f32 v81, v81
    v_exp_f32 v82, v82
    v_exp_f32 v83, v83
    v_exp_f32 v84, v84
    v_exp_f32 v85, v85
    v_exp_f32 v86, v86
    v_exp_f32 v87, v87
    s_waitcnt vmcnt(4)
    v_perm_b32 v97, v172, v168, s38
    v_perm_b32 v101, v172, v168, s39
    v_perm_b32 v105, v173, v169, s38
    v_perm_b32 v109, v173, v169, s39
    v_perm_b32 v113, v174, v170, s38
    v_perm_b32 v117, v174, v170, s39
    v_perm_b32 v121, v175, v171, s38
    v_perm_b32 v125, v175, v171, s39
    ds_write_b32 v93, v94 offset:4
    v_cvt_pk_bf16_f32 v44, v80, v81
    v_cvt_pk_bf16_f32 v45, v82, v83
    v_cvt_pk_bf16_f32 v46, v84, v85
    v_cvt_pk_bf16_f32 v47, v86, v87
    v_and_b32 v48, v40, v44
    v_and_b32 v49, v40, v45
    v_and_b32 v50, v40, v46
    v_and_b32 v51, v40, v47
    v_and_b32 v52, v41, v44
    v_and_b32 v53, v41, v45
    v_and_b32 v54, v41, v46
    v_and_b32 v55, v41, v47
    s_waitcnt vmcnt(2)
    v_perm_b32 v98, v180, v176, s38
    v_perm_b32 v102, v180, v176, s39
    v_perm_b32 v106, v181, v177, s38
    v_perm_b32 v110, v181, v177, s39
    v_perm_b32 v114, v182, v178, s38
    v_perm_b32 v118, v182, v178, s39
    v_perm_b32 v122, v183, v179, s38
    v_perm_b32 v126, v183, v179, s39
    v_and_b32 v56, v42, v44
    v_and_b32 v57, v42, v45
    v_and_b32 v58, v42, v46
    v_and_b32 v59, v42, v47
    v_and_b32 v60, v43, v44
    v_and_b32 v61, v43, v45
    v_and_b32 v62, v43, v46
    v_and_b32 v63, v43, v47
    s_waitcnt vmcnt(0)
    v_perm_b32 v99, v188, v184, s38
    v_perm_b32 v103, v188, v184, s39
    v_perm_b32 v107, v189, v185, s38
    v_perm_b32 v111, v189, v185, s39
    v_perm_b32 v115, v190, v186, s38
    v_perm_b32 v119, v190, v186, s39
    v_perm_b32 v123, v191, v187, s38
    v_perm_b32 v127, v191, v187, s39
    v_mfma_f32_16x16x32_bf16 v[32:35], v[96:99], v[48:51], v[32:35]
    v_mfma_f32_16x16x32_bf16 v[36:39], v[100:103], v[48:51], v[36:39]
    v_mfma_f32_16x16x32_bf16 v[32:35], v[104:107], v[52:55], v[32:35]
    v_mfma_f32_16x16x32_bf16 v[36:39], v[108:111], v[52:55], v[36:39]
    v_mfma_f32_16x16x32_bf16 v[32:35], v[112:115], v[56:59], v[32:35]
    v_mfma_f32_16x16x32_bf16 v[36:39], v[116:119], v[56:59], v[36:39]
    v_mfma_f32_16x16x32_bf16 v[32:35], v[120:123], v[60:63], v[32:35]
    v_mfma_f32_16x16x32_bf16 v[36:39], v[124:127], v[60:63], v[36:39]
    s_nop 6
    ds_write_b128 v95, v[32:35] offset:0
    ds_write_b128 v95, v[36:39] offset:1024

L_arrive:
    s_mov_b64 exec, 1
    ds_add_rtn_u32 v169, v93, v94
    s_mov_b64 exec, -1
    ds_read_b128 v[128:131], v10 offset:0
    ds_read_b128 v[132:135], v10 offset:1024
    ds_read_b128 v[136:139], v10 offset:2048
    ds_read_b128 v[140:143], v10 offset:3072
    ds_read_b128 v[144:147], v10 offset:4096
    ds_read_b128 v[148:151], v10 offset:5120
    ds_read_b128 v[152:155], v10 offset:6144
    ds_read_b128 v[156:159], v10 offset:7168
    ds_read_b128 v[160:163], v10 offset:8192
    ds_read_b128 v[164:167], v10 offset:9216
    ds_read_b32 v168, v15 offset:10240
    s_waitcnt lgkmcnt(11)
    v_readfirstlane_b32 s41, v169
    s_cmp_lg_u32 s41, 4
    s_cbranch_scc1 L_fin
    s_waitcnt lgkmcnt(7)
    v_add_f32 v128, v128, v136
    v_add_f32 v129, v129, v137
    v_add_f32 v130, v130, v138
    v_add_f32 v131, v131, v139
    v_add_f32 v132, v132, v140
    v_add_f32 v133, v133, v141
    v_add_f32 v134, v134, v142
    v_add_f32 v135, v135, v143
    s_waitcnt lgkmcnt(3)
    v_add_f32 v144, v144, v152
    v_add_f32 v145, v145, v153
    v_add_f32 v146, v146, v154
    v_add_f32 v147, v147, v155
    v_add_f32 v148, v148, v156
    v_add_f32 v149, v149, v157
    v_add_f32 v150, v150, v158
    v_add_f32 v151, v151, v159
    s_cmp_eq_u32 s23, 0
    s_waitcnt lgkmcnt(0)
    s_cbranch_scc1 L_out
    v_add_f32 v172, v128, v144
    v_mov_b32 v173, v168
    v_add_f32 v174, v129, v145
    v_mov_b32 v175, v168
    global_store_dwordx4 v12, v[172:175], s[20:21] offset:-2048 sc1
    v_add_f32 v176, v130, v146
    v_mov_b32 v177, v168
    v_add_f32 v178, v131, v147
    v_mov_b32 v179, v168
    global_store_dwordx4 v12, v[176:179], s[20:21] offset:-1024 sc1
    v_add_f32 v180, v132, v148
    v_mov_b32 v181, v168
    v_add_f32 v182, v133, v149
    v_mov_b32 v183, v168
    global_store_dwordx4 v12, v[180:183], s[20:21] offset:0 sc1
    v_add_f32 v184, v134, v150
    v_mov_b32 v185, v168
    v_add_f32 v186, v135, v151
    v_mov_b32 v187, v168
    global_store_dwordx4 v12, v[184:187], s[20:21] offset:1024 sc1
    global_store_dwordx4 v12, v[160:163], s[20:21] offset:2048 sc1
    s_endpgm
L_out:
    v_add_f32 v128, v128, v144
    v_add_f32 v129, v129, v145
    v_add_f32 v130, v130, v146
    v_add_f32 v131, v131, v147
    v_add_f32 v132, v132, v148
    v_add_f32 v133, v133, v149
    v_add_f32 v134, v134, v150
    v_add_f32 v135, v135, v151
    v_fma_f32 v128, v128, v168, v160
    v_fma_f32 v129, v129, v168, v161
    v_fma_f32 v130, v130, v168, v162
    v_fma_f32 v131, v131, v168, v163
    v_fma_f32 v132, v132, v168, v164
    v_fma_f32 v133, v133, v168, v165
    v_fma_f32 v134, v134, v168, v166
    v_fma_f32 v135, v135, v168, v167
    v_cvt_pk_bf16_f32 v172, v128, v132
    v_cvt_pk_bf16_f32 v173, v129, v133
    v_cvt_pk_bf16_f32 v174, v130, v134
    v_cvt_pk_bf16_f32 v175, v131, v135
    global_store_dword v13, v172, s[16:17] offset:0
    global_store_dword v13, v173, s[16:17] offset:16
    global_store_dword v13, v174, s[16:17] offset:32
    global_store_dword v13, v175, s[16:17] offset:48
L_fin:
    s_endpgm

L_helper:
    v_mov_b32 v2, 0
    v_mov_b32 v93, 10560
    v_mov_b32 v3, 0
    v_mov_b32 v94, 1
    ds_write_b64 v93, v[2:3]
    ds_write_b32 v93, v2 offset:8
    s_mov_b32 s35, 0
    s_cmp_lg_u32 s2, 0
    s_waitcnt lgkmcnt(0)
    s_barrier
    s_cbranch_scc1 L_h_notag
    s_or_b32 s44, s44, 1
    v_mov_b32 v102, s44
    v_mov_b32 v103, 0
    s_mov_b64 exec, 1
    global_atomic_cmpswap v101, v2, v[102:103], s[18:19] sc0
    s_mov_b64 exec, -1
    s_waitcnt vmcnt(0)
    v_readfirstlane_b32 s35, v101
    s_cmp_eq_u32 s35, 0
    s_cselect_b32 s35, s44, s35
L_h_notag:
    s_mov_b32 s37, 0x3e0293ee
    s_cmp_lg_u32 s23, 0
    s_cbranch_scc1 L_h_warm
    v_and_b32 v100, 3, v0
    v_lshlrev_b32 v100, 8, v100
    v_and_b32 v102, 0x3c, v0
    v_lshlrev_b32 v102, 2, v102
    s_lshl_b32 s41, s22, 10
    v_add3_u32 v101, v100, v102, s41
    global_load_dwordx4 v[44:47], v101, s[4:5]
    s_lshl_b32 s41, s22, 8
    s_add_u32 s10, s10, s41
    s_addc_u32 s11, s11, 0
    s_add_u32 s12, s12, s41
    s_addc_u32 s13, s13, 0
    s_lshr_b32 s42, s22, 4
    s_lshl_b32 s42, s42, 2
    s_load_dword s43, s[14:15], s42
    s_load_dwordx16 s[48:63], s[10:11], 0
    s_load_dwordx16 s[64:79], s[10:11], 64
    s_waitcnt lgkmcnt(0)
    v_writelane_b32 v48, s48, 0
    v_writelane_b32 v48, s49, 1
    v_writelane_b32 v48, s50, 2
    v_writelane_b32 v48, s51, 3
    v_writelane_b32 v48, s52, 4
    v_writelane_b32 v48, s53, 5
    v_writelane_b32 v48, s54, 6
    v_writelane_b32 v48, s55, 7
    v_writelane_b32 v48, s56, 8
    v_writelane_b32 v48, s57, 9
    v_writelane_b32 v48, s58, 10
    v_writelane_b32 v48, s59, 11
    v_writelane_b32 v48, s60, 12
    v_writelane_b32 v48, s61, 13
    v_writelane_b32 v48, s62, 14
    v_writelane_b32 v48, s63, 15
    v_writelane_b32 v48, s64, 16
    v_writelane_b32 v48, s65, 17
    v_writelane_b32 v48, s66, 18
    v_writelane_b32 v48, s67, 19
    v_writelane_b32 v48, s68, 20
    v_writelane_b32 v48, s69, 21
    v_writelane_b32 v48, s70, 22
    v_writelane_b32 v48, s71, 23
    v_writelane_b32 v48, s72, 24
    v_writelane_b32 v48, s73, 25
    v_writelane_b32 v48, s74, 26
    v_writelane_b32 v48, s75, 27
    v_writelane_b32 v48, s76, 28
    v_writelane_b32 v48, s77, 29
    v_writelane_b32 v48, s78, 30
    v_writelane_b32 v48, s79, 31
    s_load_dwordx16 s[48:63], s[10:11], 128
    s_load_dwordx16 s[64:79], s[10:11], 192
    s_waitcnt lgkmcnt(0)
    v_writelane_b32 v48, s48, 32
    v_writelane_b32 v48, s49, 33
    v_writelane_b32 v48, s50, 34
    v_writelane_b32 v48, s51, 35
    v_writelane_b32 v48, s52, 36
    v_writelane_b32 v48, s53, 37
    v_writelane_b32 v48, s54, 38
    v_writelane_b32 v48, s55, 39
    v_writelane_b32 v48, s56, 40
    v_writelane_b32 v48, s57, 41
    v_writelane_b32 v48, s58, 42
    v_writelane_b32 v48, s59, 43
    v_writelane_b32 v48, s60, 44
    v_writelane_b32 v48, s61, 45
    v_writelane_b32 v48, s62, 46
    v_writelane_b32 v48, s63, 47
    v_writelane_b32 v48, s64, 48
    v_writelane_b32 v48, s65, 49
    v_writelane_b32 v48, s66, 50
    v_writelane_b32 v48, s67, 51
    v_writelane_b32 v48, s68, 52
    v_writelane_b32 v48, s69, 53
    v_writelane_b32 v48, s70, 54
    v_writelane_b32 v48, s71, 55
    v_writelane_b32 v48, s72, 56
    v_writelane_b32 v48, s73, 57
    v_writelane_b32 v48, s74, 58
    v_writelane_b32 v48, s75, 59
    v_writelane_b32 v48, s76, 60
    v_writelane_b32 v48, s77, 61
    v_writelane_b32 v48, s78, 62
    v_writelane_b32 v48, s79, 63
    s_load_dwordx16 s[48:63], s[12:13], 0
    s_load_dwordx16 s[64:79], s[12:13], 64
    s_waitcnt lgkmcnt(0)
    v_writelane_b32 v49, s48, 0
    v_writelane_b32 v49, s49, 1
    v_writelane_b32 v49, s50, 2
    v_writelane_b32 v49, s51, 3
    v_writelane_b32 v49, s52, 4
    v_writelane_b32 v49, s53, 5
    v_writelane_b32 v49, s54, 6
    v_writelane_b32 v49, s55, 7
    v_writelane_b32 v49, s56, 8
    v_writelane_b32 v49, s57, 9
    v_writelane_b32 v49, s58, 10
    v_writelane_b32 v49, s59, 11
    v_writelane_b32 v49, s60, 12
    v_writelane_b32 v49, s61, 13
    v_writelane_b32 v49, s62, 14
    v_writelane_b32 v49, s63, 15
    v_writelane_b32 v49, s64, 16
    v_writelane_b32 v49, s65, 17
    v_writelane_b32 v49, s66, 18
    v_writelane_b32 v49, s67, 19
    v_writelane_b32 v49, s68, 20
    v_writelane_b32 v49, s69, 21
    v_writelane_b32 v49, s70, 22
    v_writelane_b32 v49, s71, 23
    v_writelane_b32 v49, s72, 24
    v_writelane_b32 v49, s73, 25
    v_writelane_b32 v49, s74, 26
    v_writelane_b32 v49, s75, 27
    v_writelane_b32 v49, s76, 28
    v_writelane_b32 v49, s77, 29
    v_writelane_b32 v49, s78, 30
    v_writelane_b32 v49, s79, 31
    s_load_dwordx16 s[48:63], s[12:13], 128
    s_load_dwordx16 s[64:79], s[12:13], 192
    s_waitcnt lgkmcnt(0)
    v_writelane_b32 v49, s48, 32
    v_writelane_b32 v49, s49, 33
    v_writelane_b32 v49, s50, 34
    v_writelane_b32 v49, s51, 35
    v_writelane_b32 v49, s52, 36
    v_writelane_b32 v49, s53, 37
    v_writelane_b32 v49, s54, 38
    v_writelane_b32 v49, s55, 39
    v_writelane_b32 v49, s56, 40
    v_writelane_b32 v49, s57, 41
    v_writelane_b32 v49, s58, 42
    v_writelane_b32 v49, s59, 43
    v_writelane_b32 v49, s60, 44
    v_writelane_b32 v49, s61, 45
    v_writelane_b32 v49, s62, 46
    v_writelane_b32 v49, s63, 47
    v_writelane_b32 v49, s64, 48
    v_writelane_b32 v49, s65, 49
    v_writelane_b32 v49, s66, 50
    v_writelane_b32 v49, s67, 51
    v_writelane_b32 v49, s68, 52
    v_writelane_b32 v49, s69, 53
    v_writelane_b32 v49, s70, 54
    v_writelane_b32 v49, s71, 55
    v_writelane_b32 v49, s72, 56
    v_writelane_b32 v49, s73, 57
    v_writelane_b32 v49, s74, 58
    v_writelane_b32 v49, s75, 59
    v_writelane_b32 v49, s76, 60
    v_writelane_b32 v49, s77, 61
    v_writelane_b32 v49, s78, 62
    v_writelane_b32 v49, s79, 63
    v_lshlrev_b32 v100, 2, v0
    ds_write_b32 v100, v48 offset:10752
    ds_write_b32 v100, v49 offset:11008
    v_and_b32 v103, 0x30, v0
    v_lshlrev_b32 v103, 2, v103
    v_and_b32 v101, 12, v0
    v_add_u32 v103, v103, v101
    s_waitcnt lgkmcnt(0)
    ds_read_b128 v[48:51], v102 offset:10752
    ds_read_b32 v52, v103 offset:11008
    ds_read_b32 v53, v103 offset:11024
    ds_read_b32 v54, v103 offset:11040
    ds_read_b32 v55, v103 offset:11056
    v_mov_b32 v28, 0
    s_waitcnt vmcnt(0) lgkmcnt(0)
    v_lshlrev_b32 v100, 16, v44
    v_lshlrev_b32 v101, 16, v48
    v_and_b32 v102, 0xffff0000, v44
    v_and_b32 v103, 0xffff0000, v48
    v_fmac_f32 v28, v100, v101
    v_fmac_f32 v28, v102, v103
    v_lshlrev_b32 v100, 16, v45
    v_lshlrev_b32 v101, 16, v49
    v_and_b32 v102, 0xffff0000, v45
    v_and_b32 v103, 0xffff0000, v49
    v_fmac_f32 v28, v100, v101
    v_fmac_f32 v28, v102, v103
    v_lshlrev_b32 v100, 16, v46
    v_lshlrev_b32 v101, 16, v50
    v_and_b32 v102, 0xffff0000, v46
    v_and_b32 v103, 0xffff0000, v50
    v_fmac_f32 v28, v100, v101
    v_fmac_f32 v28, v102, v103
    v_lshlrev_b32 v100, 16, v47
    v_lshlrev_b32 v101, 16, v51
    v_and_b32 v102, 0xffff0000, v47
    v_and_b32 v103, 0xffff0000, v51
    v_fmac_f32 v28, v100, v101
    v_fmac_f32 v28, v102, v103
    v_lshlrev_b32 v20, 16, v52
    v_and_b32 v24, 0xffff0000, v52
    v_lshlrev_b32 v21, 16, v53
    v_and_b32 v25, 0xffff0000, v53
    v_lshlrev_b32 v22, 16, v54
    v_and_b32 v26, 0xffff0000, v54
    v_lshlrev_b32 v23, 16, v55
    v_and_b32 v27, 0xffff0000, v55
    v_add_f32_dpp v28, v28, v28 row_ror:8 row_mask:0xf bank_mask:0xf
    s_nop 1
    v_add_f32_dpp v28, v28, v28 row_ror:4 row_mask:0xf bank_mask:0xf
    s_nop 1
    v_mov_b32 v100, v28
    s_nop 1
    v_permlane16_swap_b32 v28, v100
    v_add_f32 v28, v28, v100
    v_mov_b32 v100, v28
    s_nop 1
    v_permlane32_swap_b32 v28, v100
    v_add_f32 v28, v28, v100
    s_lshr_b32 s41, s22, 3
    s_and_b32 s41, s41, 1
    s_lshl_b32 s41, s41, 4
    s_lshr_b32 s43, s43, s41
    s_lshl_b32 s43, s43, 16
    v_sub_f32 v100, 1.0, s43
    v_mul_f32 v100, 0xceabfb8f, v100
    v_fma_f32 v28, v28, s37, v100
    s_branch L_h_notree
L_h_warm:
    s_getpc_b64 s[48:49]
L_pc:
    s_sub_u32 s48, s48, L_pc-L_kloop
    s_subb_u32 s49, s49, 0
    s_mov_b32 s50, 0
L_h_warm1:
    s_load_dword s52, s[48:49], s50
    s_add_u32 s50, s50, 64
    s_cmp_le_u32 s50, L_end-L_kloop
    s_cbranch_scc1 L_h_warm1
    s_waitcnt lgkmcnt(0)
L_h_notree:
    s_lshl_b32 s41, s3, 11
    v_add_u32 v95, s41, v10
    v_and_b32 v13, 3, v0
    v_lshlrev_b32 v13, 8, v13
    v_and_b32 v14, 0x30, v0
    v_lshl_add_u32 v13, v14, 2, v13
    v_and_b32 v14, 12, v0
    v_add_u32 v13, v13, v14
    s_lshl_b32 s41, s22, 10
    v_add_u32 v13, s41, v13
    s_lshl_b32 s41, s22, 13
    s_add_u32 s41, s41, 2048
    v_add_u32 v12, s41, v10
    v_lshlrev_b32 v15, 2, v0
    v_and_b32 v100, 3, v0
    v_lshlrev_b32 v100, 4, v100
    v_add_u32 v3, 11264, v10
L_h_ksync:
    s_sleep 8
    ds_read_b32 v101, v93 offset:8
    s_waitcnt lgkmcnt(0)
    v_readfirstlane_b32 s41, v101
    s_cmp_lg_u32 s41, 4
    s_cbranch_scc1 L_h_ksync
    ds_read_b128 v[44:47], v100 offset:10496
    s_cmp_lg_u32 s35, 0
    s_cbranch_scc1 L_h_tag
    s_load_dword s35, s[18:19], 0
    s_waitcnt lgkmcnt(0)
    s_cmp_lg_u32 s35, 0
    s_cbranch_scc1 L_h_tag
    s_or_b32 s44, s44, 1
    v_mov_b32 v102, s44
    v_mov_b32 v103, 0
    s_mov_b64 exec, 1
    global_atomic_cmpswap v101, v2, v[102:103], s[18:19] sc0
    s_mov_b64 exec, -1
    s_waitcnt vmcnt(0)
    v_readfirstlane_b32 s35, v101
    s_cmp_eq_u32 s35, 0
    s_cselect_b32 s35, s44, s35
L_h_tag:
    s_waitcnt lgkmcnt(0)
    v_max3_f32 v29, v44, v45, v46
    v_max_f32 v29, v29, v47
    v_mul_f32 v29, s37, v29
    v_mov_b32 v30, 0
    s_mov_b32 s36, 16
L_h_sum:
    ds_read_b128 v[44:47], v3
    ds_read_b128 v[48:51], v3 offset:1024
    v_add_u32 v3, 2048, v3
    s_waitcnt lgkmcnt(0)
    v_fma_f32 v44, v44, s37, -v29
    v_fma_f32 v45, v45, s37, -v29
    v_fma_f32 v46, v46, s37, -v29
    v_fma_f32 v47, v47, s37, -v29
    v_fma_f32 v48, v48, s37, -v29
    v_fma_f32 v49, v49, s37, -v29
    v_fma_f32 v50, v50, s37, -v29
    v_fma_f32 v51, v51, s37, -v29
    v_exp_f32 v44, v44
    v_exp_f32 v45, v45
    v_exp_f32 v46, v46
    v_exp_f32 v47, v47
    v_exp_f32 v48, v48
    v_exp_f32 v49, v49
    v_exp_f32 v50, v50
    v_exp_f32 v51, v51
    v_add_f32 v44, v44, v45
    v_add_f32 v46, v46, v47
    v_add_f32 v48, v48, v49
    v_add_f32 v50, v50, v51
    v_add_f32 v44, v44, v46
    v_add_f32 v48, v48, v50
    v_add_f32 v44, v44, v48
    v_add_f32 v30, v30, v44
    s_sub_u32 s36, s36, 1
    s_cmp_lg_u32 s36, 0
    s_cbranch_scc1 L_h_sum
    v_add_f32_dpp v30, v30, v30 row_ror:8 row_mask:0xf bank_mask:0xf
    s_nop 1
    v_add_f32_dpp v30, v30, v30 row_ror:4 row_mask:0xf bank_mask:0xf
    s_nop 1
    v_mov_b32 v100, v30
    s_nop 1
    v_permlane16_swap_b32 v30, v100
    v_add_f32 v30, v30, v100
    v_mov_b32 v100, v30
    s_nop 1
    v_permlane32_swap_b32 v30, v100
    v_add_f32 v30, v30, v100
    s_cmp_eq_u32 s23, 0
    s_cbranch_scc1 L_h_wait
    v_mov_b32 v44, v29
    v_mov_b32 v45, s35
    v_mov_b32 v46, v30
    v_mov_b32 v47, s35
    ds_write_b128 v95, v[44:47] offset:0
    ds_write_b32 v15, v45 offset:10240
    s_branch L_arrive
L_h_wait:
    s_sleep 4
    ds_read_b32 v102, v93 offset:4
    s_waitcnt lgkmcnt(0)
    v_readfirstlane_b32 s41, v102
    s_cmp_eq_u32 s41, 0
    s_cbranch_scc1 L_h_wait
L_h_poll:
    global_load_dwordx4 v[80:83], v12, s[20:21] offset:2048 sc1
    global_load_dwordx4 v[64:67], v12, s[20:21] offset:-2048 sc1
    global_load_dwordx4 v[68:71], v12, s[20:21] offset:-1024 sc1
    global_load_dwordx4 v[72:75], v12, s[20:21] offset:0 sc1
    global_load_dwordx4 v[76:79], v12, s[20:21] offset:1024 sc1
    s_waitcnt vmcnt(0)
    v_xor_b32 v101, s35, v65
    v_xor_b32 v102, s35, v67
    v_bitop3_b32 v101, v69, s35, v101 bitop3:0xbe
    v_bitop3_b32 v102, v71, s35, v102 bitop3:0xbe
    v_bitop3_b32 v101, v73, s35, v101 bitop3:0xbe
    v_bitop3_b32 v102, v75, s35, v102 bitop3:0xbe
    v_bitop3_b32 v101, v77, s35, v101 bitop3:0xbe
    v_bitop3_b32 v102, v79, s35, v102 bitop3:0xbe
    v_bitop3_b32 v101, v81, s35, v101 bitop3:0xbe
    v_bitop3_b32 v102, v83, s35, v102 bitop3:0xbe
    v_or_b32 v101, v101, v102
    v_cmp_ne_u32 vcc, 0, v101
    s_nop 0
    s_cbranch_vccnz L_h_poll
    v_max3_f32 v100, v29, v80, v28
    v_sub_f32 v29, v29, v100
    v_sub_f32 v80, v80, v100
    v_sub_f32 v28, v28, v100
    v_exp_f32 v29, v29
    v_exp_f32 v80, v80
    v_exp_f32 v28, v28
    s_nop 0
    v_fma_f32 v100, v30, v29, v28
    v_fmac_f32 v100, v82, v80
    v_rcp_f32 v100, v100
    s_nop 0
    v_mul_f32 v29, v29, v100
    v_mul_f32 v80, v80, v100
    v_mul_f32 v28, v28, v100
    ds_write_b32 v15, v29 offset:10240
    v_mul_f32 v20, v20, v28
    v_mul_f32 v21, v21, v28
    v_mul_f32 v22, v22, v28
    v_mul_f32 v23, v23, v28
    v_mul_f32 v24, v24, v28
    v_mul_f32 v25, v25, v28
    v_mul_f32 v26, v26, v28
    v_mul_f32 v27, v27, v28
    v_fmac_f32 v20, v64, v80
    v_fmac_f32 v21, v66, v80
    v_fmac_f32 v22, v68, v80
    v_fmac_f32 v23, v70, v80
    v_fmac_f32 v24, v72, v80
    v_fmac_f32 v25, v74, v80
    v_fmac_f32 v26, v76, v80
    v_fmac_f32 v27, v78, v80
    ds_write_b128 v95, v[20:23] offset:0
    ds_write_b128 v95, v[24:27] offset:1024
    s_branch L_arrive
L_end:
    s_endpgm
.section .rodata,"a"
.p2align 6
.amdhsa_kernel standalone__tree_speculative_verify_tree_attention_over_candidate_token_tree__sampling_kernel
  .amdhsa_next_free_vgpr 192
  .amdhsa_next_free_sgpr 80
  .amdhsa_accum_offset 192
  .amdhsa_group_segment_fixed_size 0
  .amdhsa_kernarg_size 72
  .amdhsa_user_sgpr_count 2
  .amdhsa_user_sgpr_kernarg_segment_ptr 1
  .amdhsa_system_sgpr_workgroup_id_x 1
  .amdhsa_float_denorm_mode_32 3
.end_amdhsa_kernel
```
